```python
import torch

def _softmax(x, axis=-1):
    return torch.softmax(x, dim=axis)
def _gelu(x):
    return torch.nn.functional.gelu(x, approximate="tanh")
def _silu(x):
    return torch.nn.functional.silu(x)
def _sigmoid(x):
    return torch.sigmoid(x)
def _layernorm(x, axis=-1, eps=1e-5):
    m = x.mean(dim=axis, keepdim=True)
    v = x.var(dim=axis, keepdim=True, unbiased=False)
    return (x - m) / torch.sqrt(v + eps)
def _scatter_add(tgt, idx, src, axis=0):
    return tgt.clone().index_add_(axis, idx, src)
def _segment_sum(src, seg, n):
    out = torch.zeros((n,) + src.shape[1:], dtype=src.dtype)
    return out.index_add_(0, seg, src)
def _pad(x, pw):
    flat = tuple(v for pair in reversed(pw) for v in pair)
    return torch.nn.functional.pad(x, flat)

kernel_name = 'gated_mix__sliding_block_cached__sliding_block_cached__decode'

def setup_inputs():

    _w = (lambda a: (lambda t: t.to(torch.bfloat16) if t.is_floating_point() else t)(torch.as_tensor(a)))
    def _A_setup():
        B, Sq, D = 2, 1, 1024
        Hq, Hkv, Sk, Dh = 32, 4, 32768, 128
        assert Hq % Hkv == 0, (Hq, Hkv)
        return {
            "x": _w((lambda *s: torch.randn(*s, dtype=torch.bfloat16) * 0.05)(B, Sq, D)),
            "k_cache": _w((lambda *s: torch.randn(*s, dtype=torch.bfloat16) * 6.4)(B, Hkv, Sk, Dh)),
            "v_cache": _w((lambda *s: torch.randn(*s, dtype=torch.bfloat16) * 0.05)(B, Hkv, Sk, Dh)),
            "wq": _w((lambda *s: torch.randn(*s, dtype=torch.bfloat16) * 6.4)(D, Hq * Dh) * (D ** -0.5)),
            "wo": _w((lambda *s: torch.randn(*s, dtype=torch.bfloat16) * 0.05)(Hq * Dh, D) * ((Hq * Dh) ** -0.5)),
        }
    _A_in = _A_setup()

    def _B_setup():
        B, Sq, D = 2, 1, 1024
        Hq, Hkv, Sk, Dh = 32, 4, 32768, 128
        assert Hq % Hkv == 0, (Hq, Hkv)
        return {
            "x": _w((lambda *s: torch.randn(*s, dtype=torch.bfloat16) * 0.05)(B, Sq, D)),
            "k_cache": _w((lambda *s: torch.randn(*s, dtype=torch.bfloat16) * 6.4)(B, Hkv, Sk, Dh)),
            "v_cache": _w((lambda *s: torch.randn(*s, dtype=torch.bfloat16) * 0.05)(B, Hkv, Sk, Dh)),
            "wq": _w((lambda *s: torch.randn(*s, dtype=torch.bfloat16) * 6.4)(D, Hq * Dh) * (D ** -0.5)),
            "wo": _w((lambda *s: torch.randn(*s, dtype=torch.bfloat16) * 0.05)(Hq * Dh, D) * ((Hq * Dh) ** -0.5)),
        }
    _B_in = _B_setup()

    return {
        "A_x": _A_in["x"],
        "A_k_cache": _A_in["k_cache"],
        "A_v_cache": _A_in["v_cache"],
        "A_wq": _A_in["wq"],
        "A_wo": _A_in["wo"],
        "B_x": _B_in["x"],
        "B_k_cache": _B_in["k_cache"],
        "B_v_cache": _B_in["v_cache"],
        "B_wq": _B_in["wq"],
        "B_wo": _B_in["wo"],
        "gate_w": _w((lambda *s: torch.randn(*s, dtype=torch.bfloat16) * 0.05)(1024) * 16.0),
    }

def reference(A_x, A_k_cache, A_v_cache, A_wq, A_wo, B_x, B_k_cache, B_v_cache, B_wq, B_wo, gate_w):
    def _A_ref(x, k_cache, v_cache, wq, wo):
        B, Sq, D = x.shape
        Hq, Dh = 32, 128
        Hkv, Sk = k_cache.shape[1], k_cache.shape[2]
        W = min(4096, max(256, Sk // 4))
        rep = Hq // Hkv
        q = (lambda x, *d: x.permute(*d))((x @ wq).reshape(B, Sq, Hq, Dh), 0, 2, 1, 3)
        k = (lambda x, n, axis: torch.repeat_interleave(x, n, dim=axis))(k_cache[:, :, Sk - W:, :], rep, axis=1)
        v = (lambda x, n, axis: torch.repeat_interleave(x, n, dim=axis))(v_cache[:, :, Sk - W:, :], rep, axis=1)
        scores = torch.einsum("bhqd,bhkd->bhqk", q, k) * (Dh ** -0.5)
        p = _softmax(scores, axis=-1)
        o = torch.einsum("bhqk,bhkd->bhqd", p, v)
        return (lambda x, *d: x.permute(*d))(o, 0, 2, 1, 3).reshape(B, Sq, Hq * Dh) @ wo

    def _B_ref(x, k_cache, v_cache, wq, wo):
        B, Sq, D = x.shape
        Hq, Dh = 32, 128
        Hkv, Sk = k_cache.shape[1], k_cache.shape[2]
        W = min(4096, max(256, Sk // 4))
        rep = Hq // Hkv
        q = (lambda x, *d: x.permute(*d))((x @ wq).reshape(B, Sq, Hq, Dh), 0, 2, 1, 3)
        k = (lambda x, n, axis: torch.repeat_interleave(x, n, dim=axis))(k_cache[:, :, Sk - W:, :], rep, axis=1)
        v = (lambda x, n, axis: torch.repeat_interleave(x, n, dim=axis))(v_cache[:, :, Sk - W:, :], rep, axis=1)
        scores = torch.einsum("bhqd,bhkd->bhqk", q, k) * (Dh ** -0.5)
        p = _softmax(scores, axis=-1)
        o = torch.einsum("bhqk,bhkd->bhqd", p, v)
        return (lambda x, *d: x.permute(*d))(o, 0, 2, 1, 3).reshape(B, Sq, Hq * Dh) @ wo

    x = A_x
    g = _sigmoid((x * gate_w).sum(-1, keepdims=True))
    a = _A_ref(x, A_k_cache, A_v_cache, A_wq, A_wo)
    b = _B_ref(x, B_k_cache, B_v_cache, B_wq, B_wo)
    return g * a + (1 - g) * b
```

```asm
; @launch grid=(256,1,1) block=(576,1,1) lds=163840
.amdgcn_target "amdgcn-amd-amdhsa--gfx950"
.text
.globl gated_mix__sliding_block_cached__sliding_block_cached__decode_kernel
.p2align 8
.type gated_mix__sliding_block_cached__sliding_block_cached__decode_kernel,@function
gated_mix__sliding_block_cached__sliding_block_cached__decode_kernel:
    s_cmp_ge_u32 s2, 256
    s_cbranch_scc1 L_end
    s_load_dwordx16 s[4:19], s[0:1], 0
    s_load_dwordx8 s[20:27], s[0:1], 64
    s_load_dwordx4 s[28:31], s[0:1], 96
    v_lshrrev_b32 v4, 6, v0
    v_and_b32 v1, 63, v0
    v_readfirstlane_b32 s32, v4
    v_and_b32 v2, 15, v0
    v_bfe_u32 v3, v0, 4, 2
    s_and_b32 s33, s2, 7
    s_lshr_b32 s34, s33, 2
    s_and_b32 s35, s33, 3
    s_lshr_b32 s36, s2, 3
    s_lshr_b32 s37, s36, 4
    s_and_b32 s38, s36, 15
    s_lshr_b32 s39, s36, 2
    s_and_b32 s84, s36, 3
    v_mov_b32 v16, 160480
    v_mov_b32 v154, 1
    s_cmp_eq_u32 s32, 8
    s_cbranch_scc1 L_loader
    v_lshrrev_b32 v4, 2, v2
    v_and_b32 v5, 3, v2
    v_and_b32 v7, 1, v3
    v_lshlrev_b32 v7, 3, v7
    v_lshl_or_b32 v7, v4, 1, v7
    v_lshrrev_b32 v6, 1, v5
    v_lshl_add_u32 v8, v3, 3, v4
    v_and_b32 v5, 1, v5
    v_lshlrev_b32 v5, 3, v5
    s_lshl_b32 s77, s32, 1
    v_add_u32 v9, s77, v6
    v_xor_b32 v9, v9, v7
    v_lshl_add_u32 v9, v9, 4, v5
    v_lshl_add_u32 v9, v8, 8, v9
    v_add_u32 v20, 65536, v9
    s_lshl_b32 s77, s32, 2
    s_add_u32 s77, s77, 0
    v_add_u32 v9, s77, v6
    v_xor_b32 v9, v9, v7
    v_lshl_add_u32 v9, v9, 4, v5
    v_lshl_add_u32 v9, v8, 9, v9
    v_add_u32 v36, 131072, v9
    v_add_u32 v38, 0, v9
    s_lshl_b32 s77, s32, 2
    s_add_u32 s77, s77, 2
    v_add_u32 v9, s77, v6
    v_xor_b32 v9, v9, v7
    v_lshl_add_u32 v9, v9, 4, v5
    v_lshl_add_u32 v9, v8, 9, v9
    v_add_u32 v37, 131072, v9
    v_add_u32 v39, 0, v9
    s_waitcnt lgkmcnt(0)
    s_mov_b32 s60, s4
    s_and_b32 s61, s5, 0xffff
    s_mov_b32 s62, 4096
    s_mov_b32 s63, 0x20000
    s_mov_b32 s56, s30
    s_and_b32 s57, s31, 0xffff
    s_mov_b32 s58, 302000128
    s_mov_b32 s59, 0x20000
    s_load_dword s68, s[30:31], 0
    s_lshr_b32 s92, s2, 0
    s_and_b32 s92, s92, 1
    s_cmp_eq_u32 s32, 0
    s_cbranch_scc0 L_nox
    v_lshrrev_b32 v4, 5, v1
    v_and_b32 v5, 31, v1
    v_lshlrev_b32 v6, 11, v4
    v_lshl_add_u32 v6, v5, 4, v6
    s_lshl_b32 s77, s84, 9
    buffer_load_dwordx4 v[48:51], v6, s[60:63], s77 offen
    v_mov_b32 v7, 0
    v_lshl_add_u32 v8, v1, 2, v16
    s_mov_b64 exec, 0xffff
    ds_write_b32 v8, v7
    s_mov_b64 exec, -1
    v_mul_u32_u24 v4, 544, v4
    v_lshl_add_u32 v4, v5, 4, v4
    v_add_u32 v10, 159392, v4
    s_waitcnt lgkmcnt(0)
L_nox:
    s_cmp_eq_u32 s32, 2
    s_cbranch_scc0 L_notouch
    s_cmp_eq_u32 s34, 0
    s_cselect_b32 s44, s6, s16
    s_cselect_b32 s45, s7, s17
    s_mov_b32 s46, 67108864
    s_mov_b32 s47, 0x20000
    s_cselect_b32 s48, s8, s18
    s_cselect_b32 s49, s9, s19
    s_mov_b32 s50, 67108864
    s_mov_b32 s51, 0x20000
    s_cselect_b32 s52, s12, s22
    s_cselect_b32 s53, s13, s23
    s_mov_b32 s54, 8388608
    s_mov_b32 s55, 0x20000
    s_lshl_b32 s73, s37, 2
    s_add_u32 s73, s73, s35
    s_lshl_b32 s73, s73, 23
    s_add_u32 s73, s73, 7340032
    s_lshl_b32 s77, s38, 16
    s_add_u32 s73, s73, s77
    s_lshl_b32 s77, s35, 3
    s_add_u32 s77, s77, s39
    s_lshl_b32 s74, s77, 18
    v_mov_b32 v4, 0
    s_mov_b64 exec, 1
    buffer_load_dword v156, v4, s[48:51], s73 offen nt
    buffer_load_dword v157, v4, s[44:47], s73 offen nt
    s_mov_b64 exec, -1
L_notouch:
    s_mov_b32 s64, s24
    s_and_b32 s65, s25, 0xffff
    s_mov_b32 s66, 2048
    s_mov_b32 s67, 0x20000
    s_cmp_eq_u32 s32, 1
    s_cbranch_scc0 L_nogload
    s_cmp_lt_u32 s2, 128
    s_cbranch_scc0 L_nogload
    v_lshlrev_b32 v6, 5, v1
    s_lshl_b32 s79, s92, 11
    buffer_load_dwordx4 v[96:99], v6, s[60:63], s79 offen
    buffer_load_dwordx4 v[100:103], v6, s[60:63], s79 offen offset:16
    buffer_load_dwordx4 v[104:107], v6, s[64:67], 0 offen
    buffer_load_dwordx4 v[108:111], v6, s[64:67], 0 offen offset:16
L_nogload:
    s_mov_b32 s64, s26
    s_and_b32 s65, s27, 0xffff
    s_mov_b32 s66, 4096
    s_mov_b32 s67, 0x20000
    s_barrier
    s_cmp_eq_u32 s32, 0
    s_cbranch_scc0 L_nox2
    s_waitcnt vmcnt(0)
    ds_write_b128 v10, v[48:51]
    s_mov_b64 exec, 1
    ds_write_b32 v16, v154 offset:20
    s_mov_b64 exec, -1
L_nox2:
    s_mov_b32 s69, 0xffffff00
    s_mov_b32 s70, 0x3fb8aa3b
    s_mov_b32 s71, 0x3db504f3
    s_mov_b32 s85, 8192
    v_cmp_le_u32 s[90:91], 8, v2
    v_and_b32 v17, 7, v2
    s_lshl_b32 s77, s32, 13
    v_add_u32 v4, 0, v3
    v_xor_b32 v4, v4, v2
    v_lshlrev_b32 v4, 4, v4
    v_lshl_add_u32 v4, v2, 8, v4
    v_add_u32 v21, s77, v4
    v_add_u32 v4, 4, v3
    v_xor_b32 v4, v4, v2
    v_lshlrev_b32 v4, 4, v4
    v_lshl_add_u32 v4, v2, 8, v4
    v_add_u32 v22, s77, v4
    v_add_u32 v4, 8, v3
    v_xor_b32 v4, v4, v2
    v_lshlrev_b32 v4, 4, v4
    v_lshl_add_u32 v4, v2, 8, v4
    v_add_u32 v23, s77, v4
    v_add_u32 v4, 12, v3
    v_xor_b32 v4, v4, v2
    v_lshlrev_b32 v4, 4, v4
    v_lshl_add_u32 v4, v2, 8, v4
    v_add_u32 v24, s77, v4
    v_mul_u32_u24 v18, 288, v17
    v_lshl_add_u32 v18, v3, 4, v18
    v_add_u32 v18, 151808, v18
    v_mul_u32_u24 v19, 544, v17
    v_lshl_add_u32 v19, v3, 4, v19
    v_add_u32 v19, 147456, v19
    v_and_b32 v4, 1, v2
    v_mul_u32_u24 v35, 544, v4
    v_lshl_add_u32 v35, v3, 4, v35
    v_add_u32 v35, 159392, v35
    v_mul_u32_u24 v150, 272, v4
    v_lshl_add_u32 v150, v3, 4, v150
    v_add_u32 v150, 158848, v150
    s_mul_i32 s78, s38, 1
    s_lshl_b32 s79, s33, 1
    s_add_u32 s79, s79, s37
    s_mul_i32 s79, s79, 5
    s_add_u32 s78, s78, s79
    s_and_b32 s78, s78, 15
    s_lshl_b32 s78, s78, 4
    v_mul_u32_u24 v6, 272, v4
    v_add_u32 v6, 158848, v6
    v_lshlrev_b32 v5, 4, v3
    s_add_u32 s79, s78, 0
    v_add_u32 v5, s79, v5
    v_and_b32 v5, 0xff, v5
    v_add_u32 v161, v5, v6
    v_lshlrev_b32 v5, 4, v3
    s_add_u32 s79, s78, 64
    v_add_u32 v5, s79, v5
    v_and_b32 v5, 0xff, v5
    v_add_u32 v162, v5, v6
    v_lshlrev_b32 v5, 4, v3
    s_add_u32 s79, s78, 128
    v_add_u32 v5, s79, v5
    v_and_b32 v5, 0xff, v5
    v_add_u32 v163, v5, v6
    v_lshlrev_b32 v5, 4, v3
    s_add_u32 s79, s78, 192
    v_add_u32 v5, s79, v5
    v_and_b32 v5, 0xff, v5
    v_add_u32 v164, v5, v6
    v_lshlrev_b32 v25, 5, v17
    v_add_u32 v25, 158336, v25
    s_lshl_b32 s77, s33, 5
    s_add_u32 s77, s77, s36
    s_lshl_b32 s78, s77, 10
    s_lshl_b32 s79, s32, 6
    s_add_u32 s78, s78, s79
    s_add_u32 s78, s78, 65536
    v_lshlrev_b32 v5, 9, v4
    v_lshl_add_u32 v5, v3, 4, v5
    v_add_u32 v152, s78, v5
    s_lshl_b32 s79, s32, 6
    s_lshl_b32 s78, s77, 12
    s_add_u32 s78, s78, 1048576
    s_add_u32 s78, s78, s79
    v_lshlrev_b32 v5, 9, v17
    v_lshl_add_u32 v5, v3, 4, v5
    v_add_u32 v153, s78, v5
    s_lshl_b32 s77, s33, 15
    s_lshl_b32 s78, s32, 12
    s_add_u32 s77, s77, s78
    s_lshl_b32 s78, s37, 9
    s_add_u32 s77, s77, s78
    s_add_u32 s77, s77, 65536
    v_lshlrev_b32 v5, 4, v2
    v_lshl_add_u32 v27, v3, 10, v5
    v_add_u32 v27, s77, v27
    s_lshl_b32 s77, s33, 17
    s_lshl_b32 s78, s39, 9
    s_add_u32 s77, s77, s78
    s_lshr_b32 s78, s32, 2
    s_lshl_b32 s78, s78, 16
    s_add_u32 s77, s77, s78
    s_and_b32 s78, s32, 3
    s_lshl_b32 s78, s78, 7
    s_add_u32 s77, s77, s78
    s_add_u32 s77, s77, 1048576
    v_lshrrev_b32 v6, 3, v1
    v_and_b32 v5, 7, v1
    v_lshlrev_b32 v7, 4, v5
    v_lshl_add_u32 v28, v6, 12, v7
    v_add_u32 v28, s77, v28
    v_add_u32 v29, 0x8000, v28
    v_lshrrev_b32 v6, 2, v1
    v_and_b32 v5, 3, v1
    s_lshl_b32 s78, s33, 12
    s_lshl_b32 s79, s39, 4
    s_add_u32 s78, s78, s79
    s_add_u32 s78, s78, 393216
    v_and_b32 v7, 1, v1
    v_lshlrev_b32 v7, 11, v7
    v_lshl_add_u32 v30, v6, 7, v7
    v_add_u32 v30, s78, v30
    s_lshl_b32 s77, s33, 3
    s_add_u32 s77, s77, s39
    s_lshl_b32 s77, s77, 6
    s_lshl_b32 s78, s84, 3
    s_add_u32 s78, s78, s32
    s_lshl_b32 s78, s78, 14
    s_add_u32 s77, s77, s78
    s_add_u32 s77, s77, 2097152
    v_lshlrev_b32 v7, 12, v4
    v_lshl_add_u32 v7, v3, 4, v7
    v_add_u32 v31, s77, v7
    s_and_b32 s77, s2, 127
    s_lshl_b32 s77, s77, 12
    s_add_u32 s77, s77, 2097152
    v_lshlrev_b32 v33, 4, v1
    v_add_u32 v33, s77, v33
    v_and_b32 v7, 7, v1
    v_lshlrev_b32 v151, 3, v7
    v_lshl_add_u32 v151, v3, 1, v151
    s_lshr_b32 s77, s32, 2
    s_mul_i32 s77, s77, 272
    s_and_b32 s78, s32, 3
    s_lshl_b32 s78, s78, 6
    s_add_u32 s77, s77, s78
    s_add_u32 s77, s77, 158848
    v_add_u32 v151, s77, v151
    s_waitcnt lgkmcnt(0)
    s_add_u32 s68, s68, 0x9E3779B9
    s_bfe_u32 s77, s68, 524288
    v_mov_b32 v12, s77
    s_bfe_u32 s77, s68, 524296
    v_mov_b32 v13, s77
    s_bfe_u32 s77, s68, 524304
    v_mov_b32 v14, s77
    s_bfe_u32 s77, s68, 524312
    v_mov_b32 v15, s77
    s_cmp_eq_u32 s32, 3
    s_cbranch_scc0 L_noxc
    s_getreg_b32 s86, hwreg(HW_REG_XCC_ID, 0, 4)
    s_lshl_b32 s78, s86, 8
    v_or_b32 v48, s78, v12
    v_or_b32 v49, s78, v13
    v_or_b32 v50, s78, v14
    v_or_b32 v51, s78, v15
    s_lshl_b32 s77, s33, 5
    s_add_u32 s79, s77, s36
    s_lshl_b32 s79, s79, 7
    s_add_u32 s79, s79, 458752
    v_lshlrev_b32 v4, 4, v1
    s_mov_b64 exec, 0xff
    buffer_store_dwordx4 v[48:51], v4, s[56:59], s79 offen sc1
    s_mov_b64 exec, -1
    s_lshl_b32 s77, s77, 7
    s_add_u32 s77, s77, 458752
    v_and_b32 v5, 31, v1
    v_lshlrev_b32 v5, 7, v5
    v_add_u32 v5, s77, v5
    s_waitcnt vmcnt(0)
    s_mov_b32 s76, 0
    s_mov_b32 s82, -1
    s_mov_b32 s83, 0
L_xc_retry:
    s_add_u32 s76, s76, 1
    s_cmp_ge_u32 s76, 200000
    s_cbranch_scc1 L_xc_out
    s_mov_b64 exec, s[82:83]
    buffer_load_dwordx4 v[52:55], v5, s[56:59], 0 offen sc1
    s_waitcnt vmcnt(0)
    v_xor_b32 v52, v52, v12
    v_xor_b32 v53, v53, v13
    v_xor_b32 v54, v54, v14
    v_xor_b32 v55, v55, v15
    v_or3_b32 v6, v52, v53, v54
    v_or_b32 v6, v6, v55
    v_and_b32 v6, 0xff, v6
    v_cmp_ne_u32 s[82:83], 0, v6
    s_nop 0
    s_cmp_lg_u64 s[82:83], 0
    s_cbranch_scc1 L_xc_retry
L_xc_out:
    s_mov_b32 exec_lo, -1
    s_mov_b32 exec_hi, 0
    v_lshrrev_b32 v6, 8, v52
    v_cmp_ne_u32 vcc, s86, v6
    s_mov_b64 exec, -1
    s_or_b64 vcc, vcc, s[82:83]
    s_cselect_b32 s77, 2, 1
    v_mov_b32 v6, s77
    s_mov_b64 exec, 1
    ds_write_b32 v16, v6 offset:60
    s_mov_b64 exec, -1
L_noxc:
    s_cmp_eq_u32 s32, 1
    s_cbranch_scc0 L_nogate
    s_cmp_lt_u32 s2, 128
    s_cbranch_scc0 L_nogate
    s_waitcnt vmcnt(0)
    v_mov_b32 v4, 0
    v_lshlrev_b32 v5, 16, v96
    v_and_b32 v6, 0xffff0000, v96
    v_lshlrev_b32 v7, 16, v104
    v_and_b32 v8, 0xffff0000, v104
    v_mul_f32 v5, v5, v7
    v_mul_f32 v6, v6, v8
    v_cvt_pk_bf16_f32 v5, v5, v6
    v_lshlrev_b32 v6, 16, v5
    v_and_b32 v5, 0xffff0000, v5
    v_add_f32 v4, v4, v6
    v_add_f32 v4, v4, v5
    v_lshlrev_b32 v5, 16, v97
    v_and_b32 v6, 0xffff0000, v97
    v_lshlrev_b32 v7, 16, v105
    v_and_b32 v8, 0xffff0000, v105
    v_mul_f32 v5, v5, v7
    v_mul_f32 v6, v6, v8
    v_cvt_pk_bf16_f32 v5, v5, v6
    v_lshlrev_b32 v6, 16, v5
    v_and_b32 v5, 0xffff0000, v5
    v_add_f32 v4, v4, v6
    v_add_f32 v4, v4, v5
    v_lshlrev_b32 v5, 16, v98
    v_and_b32 v6, 0xffff0000, v98
    v_lshlrev_b32 v7, 16, v106
    v_and_b32 v8, 0xffff0000, v106
    v_mul_f32 v5, v5, v7
    v_mul_f32 v6, v6, v8
    v_cvt_pk_bf16_f32 v5, v5, v6
    v_lshlrev_b32 v6, 16, v5
    v_and_b32 v5, 0xffff0000, v5
    v_add_f32 v4, v4, v6
    v_add_f32 v4, v4, v5
    v_lshlrev_b32 v5, 16, v99
    v_and_b32 v6, 0xffff0000, v99
    v_lshlrev_b32 v7, 16, v107
    v_and_b32 v8, 0xffff0000, v107
    v_mul_f32 v5, v5, v7
    v_mul_f32 v6, v6, v8
    v_cvt_pk_bf16_f32 v5, v5, v6
    v_lshlrev_b32 v6, 16, v5
    v_and_b32 v5, 0xffff0000, v5
    v_add_f32 v4, v4, v6
    v_add_f32 v4, v4, v5
    v_lshlrev_b32 v5, 16, v100
    v_and_b32 v6, 0xffff0000, v100
    v_lshlrev_b32 v7, 16, v108
    v_and_b32 v8, 0xffff0000, v108
    v_mul_f32 v5, v5, v7
    v_mul_f32 v6, v6, v8
    v_cvt_pk_bf16_f32 v5, v5, v6
    v_lshlrev_b32 v6, 16, v5
    v_and_b32 v5, 0xffff0000, v5
    v_add_f32 v4, v4, v6
    v_add_f32 v4, v4, v5
    v_lshlrev_b32 v5, 16, v101
    v_and_b32 v6, 0xffff0000, v101
    v_lshlrev_b32 v7, 16, v109
    v_and_b32 v8, 0xffff0000, v109
    v_mul_f32 v5, v5, v7
    v_mul_f32 v6, v6, v8
    v_cvt_pk_bf16_f32 v5, v5, v6
    v_lshlrev_b32 v6, 16, v5
    v_and_b32 v5, 0xffff0000, v5
    v_add_f32 v4, v4, v6
    v_add_f32 v4, v4, v5
    v_lshlrev_b32 v5, 16, v102
    v_and_b32 v6, 0xffff0000, v102
    v_lshlrev_b32 v7, 16, v110
    v_and_b32 v8, 0xffff0000, v110
    v_mul_f32 v5, v5, v7
    v_mul_f32 v6, v6, v8
    v_cvt_pk_bf16_f32 v5, v5, v6
    v_lshlrev_b32 v6, 16, v5
    v_and_b32 v5, 0xffff0000, v5
    v_add_f32 v4, v4, v6
    v_add_f32 v4, v4, v5
    v_lshlrev_b32 v5, 16, v103
    v_and_b32 v6, 0xffff0000, v103
    v_lshlrev_b32 v7, 16, v111
    v_and_b32 v8, 0xffff0000, v111
    v_mul_f32 v5, v5, v7
    v_mul_f32 v6, v6, v8
    v_cvt_pk_bf16_f32 v5, v5, v6
    v_lshlrev_b32 v6, 16, v5
    v_and_b32 v5, 0xffff0000, v5
    v_add_f32 v4, v4, v6
    v_add_f32 v4, v4, v5
    s_nop 1
    v_add_f32_dpp v4, v4, v4 quad_perm:[1,0,3,2] row_mask:0xf bank_mask:0xf
    s_nop 1
    v_add_f32_dpp v4, v4, v4 quad_perm:[2,3,0,1] row_mask:0xf bank_mask:0xf
    s_nop 1
    v_add_f32_dpp v4, v4, v4 row_ror:4 row_mask:0xf bank_mask:0xf
    s_nop 1
    v_add_f32_dpp v4, v4, v4 row_ror:8 row_mask:0xf bank_mask:0xf
    v_mov_b32 v5, v4
    s_nop 1
    v_permlane16_swap_b32 v4, v5
    v_add_f32 v4, v4, v5
    v_mov_b32 v5, v4
    s_nop 1
    v_permlane32_swap_b32 v4, v5
    v_add_f32 v4, v4, v5
    v_cvt_pk_bf16_f32 v4, v4, v4
    v_lshlrev_b32 v4, 16, v4
    v_mul_f32 v4, s70, v4
    v_sub_f32 v4, 0, v4
    v_exp_f32 v4, v4
    s_nop 0
    v_add_f32 v4, 1.0, v4
    v_rcp_f32 v4, v4
    s_nop 0
    v_cvt_pk_bf16_f32 v4, v4, v4
    v_lshlrev_b32 v4, 16, v4
    v_sub_f32 v5, 1.0, v4
    v_cvt_pk_bf16_f32 v5, v5, v5
    v_lshlrev_b32 v5, 16, v5
    v_cmp_le_u32 vcc, 32, v1
    s_nop 1
    v_cndmask_b32 v34, v4, v5, vcc
L_nogate:
    s_mov_b32 s81, 0
L_w_1:
    ds_read_b32 v11, v16 offset:20
    s_add_u32 s81, s81, 1
    s_cmp_ge_u32 s81, 2000000
    s_cbranch_scc1 L_w_1x
    s_waitcnt lgkmcnt(0)
    v_readfirstlane_b32 s79, v11
    s_nop 0
    s_cmp_ge_u32 s79, 1
    s_cbranch_scc0 L_w_1
L_w_1x:
    s_waitcnt lgkmcnt(0)
    ds_read_b128 v[64:67], v35 offset:0
    ds_read_b128 v[68:71], v35 offset:64
    ds_read_b128 v[72:75], v35 offset:128
    ds_read_b128 v[76:79], v35 offset:192
    ds_read_b128 v[80:83], v35 offset:256
    ds_read_b128 v[84:87], v35 offset:320
    ds_read_b128 v[88:91], v35 offset:384
    ds_read_b128 v[92:95], v35 offset:448
    s_mov_b32 s81, 0
L_w_2:
    ds_read_b32 v11, v16 offset:60
    s_add_u32 s81, s81, 1
    s_cmp_ge_u32 s81, 2000000
    s_cbranch_scc1 L_w_2x
    s_waitcnt lgkmcnt(0)
    v_readfirstlane_b32 s79, v11
    s_nop 0
    s_cmp_ge_u32 s79, 1
    s_cbranch_scc0 L_w_2
L_w_2x:
    s_waitcnt lgkmcnt(0)
    s_mov_b32 s86, s79
    s_mov_b32 s81, 0
L_w_3:
    ds_read_b32 v11, v16 offset:0
    s_add_u32 s81, s81, 1
    s_cmp_ge_u32 s81, 2000000
    s_cbranch_scc1 L_w_3x
    s_waitcnt lgkmcnt(0)
    v_readfirstlane_b32 s79, v11
    s_nop 0
    s_cmp_ge_u32 s79, 1
    s_cbranch_scc0 L_w_3
L_w_3x:
    s_waitcnt lgkmcnt(0)
    ds_read_b64_tr_b16 v[96:97], v20 offset:0
    ds_read_b64_tr_b16 v[98:99], v20 offset:1024
    ds_read_b64_tr_b16 v[100:101], v20 offset:8192
    ds_read_b64_tr_b16 v[102:103], v20 offset:9216
    ds_read_b64_tr_b16 v[104:105], v20 offset:16384
    ds_read_b64_tr_b16 v[106:107], v20 offset:17408
    ds_read_b64_tr_b16 v[108:109], v20 offset:24576
    ds_read_b64_tr_b16 v[110:111], v20 offset:25600
    ds_read_b64_tr_b16 v[112:113], v20 offset:32768
    ds_read_b64_tr_b16 v[114:115], v20 offset:33792
    ds_read_b64_tr_b16 v[116:117], v20 offset:40960
    ds_read_b64_tr_b16 v[118:119], v20 offset:41984
    ds_read_b64_tr_b16 v[120:121], v20 offset:49152
    ds_read_b64_tr_b16 v[122:123], v20 offset:50176
    ds_read_b64_tr_b16 v[124:125], v20 offset:57344
    ds_read_b64_tr_b16 v[126:127], v20 offset:58368
    s_mov_b64 exec, 1
    ds_add_u32 v16, v154 offset:24
    s_mov_b64 exec, -1
    s_waitcnt lgkmcnt(15)
    v_mfma_f32_16x16x32_bf16 v[40:43], v[96:99], v[64:67], 0
    s_waitcnt lgkmcnt(13)
    v_mfma_f32_16x16x32_bf16 v[40:43], v[100:103], v[68:71], v[40:43]
    s_waitcnt lgkmcnt(11)
    v_mfma_f32_16x16x32_bf16 v[40:43], v[104:107], v[72:75], v[40:43]
    s_waitcnt lgkmcnt(9)
    v_mfma_f32_16x16x32_bf16 v[40:43], v[108:111], v[76:79], v[40:43]
    s_waitcnt lgkmcnt(7)
    v_mfma_f32_16x16x32_bf16 v[40:43], v[112:115], v[80:83], v[40:43]
    s_waitcnt lgkmcnt(5)
    v_mfma_f32_16x16x32_bf16 v[40:43], v[116:119], v[84:87], v[40:43]
    s_waitcnt lgkmcnt(3)
    v_mfma_f32_16x16x32_bf16 v[40:43], v[120:123], v[88:91], v[40:43]
    s_waitcnt lgkmcnt(1)
    v_mfma_f32_16x16x32_bf16 v[40:43], v[124:127], v[92:95], v[40:43]
    s_nop 7
    v_and_or_b32 v40, v40, s69, v12
    v_and_or_b32 v41, v41, s69, v13
    v_and_or_b32 v42, v42, s69, v14
    v_and_or_b32 v43, v43, s69, v15
    s_mov_b32 exec_lo, 0x00030003
    s_mov_b32 exec_hi, 0x00030003
    s_cmp_eq_u32 s86, 1
    s_cbranch_scc1 L_st_4f
    buffer_store_dwordx4 v[40:43], v152, s[56:59], 0 offen sc1
    s_branch L_st_4d
L_st_4f:
    buffer_store_dwordx4 v[40:43], v152, s[56:59], 0 offen
L_st_4d:
    s_mov_b64 exec, -1
    s_mov_b32 s81, 0
L_w_5:
    ds_read_b32 v11, v16 offset:4
    s_add_u32 s81, s81, 1
    s_cmp_ge_u32 s81, 2000000
    s_cbranch_scc1 L_w_5x
    s_waitcnt lgkmcnt(0)
    v_readfirstlane_b32 s79, v11
    s_nop 0
    s_cmp_ge_u32 s79, 1
    s_cbranch_scc0 L_w_5
L_w_5x:
    s_waitcnt lgkmcnt(0)
    buffer_load_dwordx4 v[48:51], v27, s[56:59], 0 offen
    buffer_load_dwordx4 v[52:55], v27, s[56:59], 0 offen offset:256
    s_mov_b32 s76, 0
    s_waitcnt vmcnt(0)
    v_xor_b32 v48, v48, v12
    v_xor_b32 v49, v49, v13
    v_xor_b32 v50, v50, v14
    v_xor_b32 v51, v51, v15
    v_or3_b32 v4, v48, v49, v50
    v_or_b32 v4, v4, v51
    v_xor_b32 v52, v52, v12
    v_xor_b32 v53, v53, v13
    v_xor_b32 v54, v54, v14
    v_xor_b32 v55, v55, v15
    v_or3_b32 v4, v4, v52, v53
    v_or3_b32 v4, v4, v54, v55
    v_and_b32 v4, 0xff, v4
    v_cmp_ne_u32 s[82:83], 0, v4
    s_nop 0
    s_cmp_eq_u64 s[82:83], 0
    s_cbranch_scc1 L_h1_ok
L_h1_retry:
    s_add_u32 s76, s76, 1
    s_cmp_ge_u32 s76, 200000
    s_cbranch_scc1 L_h1_out
    s_mov_b64 exec, s[82:83]
    buffer_load_dwordx4 v[48:51], v27, s[56:59], 0 offen sc1
    buffer_load_dwordx4 v[52:55], v27, s[56:59], 0 offen offset:256 sc1
    s_waitcnt vmcnt(0)
    v_xor_b32 v48, v48, v12
    v_xor_b32 v49, v49, v13
    v_xor_b32 v50, v50, v14
    v_xor_b32 v51, v51, v15
    v_or3_b32 v4, v48, v49, v50
    v_or_b32 v4, v4, v51
    v_xor_b32 v52, v52, v12
    v_xor_b32 v53, v53, v13
    v_xor_b32 v54, v54, v14
    v_xor_b32 v55, v55, v15
    v_or3_b32 v4, v4, v52, v53
    v_or3_b32 v4, v4, v54, v55
    v_and_b32 v4, 0xff, v4
    v_cmp_ne_u32 s[82:83], 0, v4
    s_nop 0
    s_cmp_lg_u64 s[82:83], 0
    s_cbranch_scc1 L_h1_retry
L_h1_out:
    s_mov_b64 exec, -1
L_h1_ok:
    v_permlane32_swap_b32 v48, v52
    v_permlane32_swap_b32 v49, v53
    v_permlane32_swap_b32 v50, v54
    v_permlane32_swap_b32 v51, v55
    v_add_f32 v48, v48, v52
    v_add_f32 v49, v49, v53
    v_add_f32 v50, v50, v54
    v_add_f32 v51, v51, v55
    s_nop 0
    v_permlane16_swap_b32 v48, v50
    v_permlane16_swap_b32 v49, v51
    v_add_f32 v48, v48, v50
    v_add_f32 v49, v49, v51
    v_cvt_pk_bf16_f32 v4, v48, v49
    s_mul_i32 s77, s32, 288
    s_add_u32 s77, s77, 151808
    v_lshrrev_b32 v5, 1, v3
    v_lshlrev_b32 v5, 7, v5
    v_lshl_add_u32 v5, v2, 3, v5
    v_and_b32 v6, 1, v3
    v_lshl_add_u32 v5, v6, 2, v5
    v_add_u32 v5, s77, v5
    ds_write_b32 v5, v4
    s_mov_b64 exec, 1
    ds_add_u32 v16, v154 offset:28
    s_mov_b64 exec, -1
    s_mov_b32 s81, 0
L_w_6:
    ds_read_b32 v11, v16 offset:8
    s_add_u32 s81, s81, 1
    s_cmp_ge_u32 s81, 2000000
    s_cbranch_scc1 L_w_6x
    s_waitcnt lgkmcnt(0)
    v_readfirstlane_b32 s79, v11
    s_nop 0
    s_cmp_ge_u32 s79, 1
    s_cbranch_scc0 L_w_6
L_w_6x:
    s_waitcnt lgkmcnt(0)
    ds_read_b128 v[96:99], v21 offset:0
    ds_read_b128 v[100:103], v22 offset:0
    ds_read_b128 v[104:107], v23 offset:0
    ds_read_b128 v[108:111], v24 offset:0
    ds_read_b128 v[112:115], v21 offset:4096
    ds_read_b128 v[116:119], v22 offset:4096
    ds_read_b128 v[120:123], v23 offset:4096
    ds_read_b128 v[124:127], v24 offset:4096
    s_mov_b32 s81, 0
L_w_7:
    ds_read_b32 v11, v16 offset:28
    s_add_u32 s81, s81, 1
    s_cmp_ge_u32 s81, 2000000
    s_cbranch_scc1 L_w_7x
    s_waitcnt lgkmcnt(0)
    v_readfirstlane_b32 s79, v11
    s_nop 0
    s_cmp_ge_u32 s79, 8
    s_cbranch_scc0 L_w_7
L_w_7x:
    s_waitcnt lgkmcnt(0)
    ds_read_b128 v[128:131], v18 offset:0
    ds_read_b128 v[132:135], v18 offset:64
    ds_read_b128 v[136:139], v18 offset:128
    ds_read_b128 v[140:143], v18 offset:192
    s_waitcnt lgkmcnt(0)
    v_mfma_f32_16x16x32_bf16 v[40:43], v[96:99], v[128:131], 0
    v_mfma_f32_16x16x32_bf16 v[44:47], v[112:115], v[128:131], 0
    v_mfma_f32_16x16x32_bf16 v[40:43], v[100:103], v[132:135], v[40:43]
    v_mfma_f32_16x16x32_bf16 v[44:47], v[116:119], v[132:135], v[44:47]
    v_mfma_f32_16x16x32_bf16 v[40:43], v[104:107], v[136:139], v[40:43]
    v_mfma_f32_16x16x32_bf16 v[44:47], v[120:123], v[136:139], v[44:47]
    v_mfma_f32_16x16x32_bf16 v[40:43], v[108:111], v[140:143], v[40:43]
    v_mfma_f32_16x16x32_bf16 v[44:47], v[124:127], v[140:143], v[44:47]
    s_nop 6
    v_cvt_pk_bf16_f32 v4, v40, v41
    v_lshlrev_b32 v40, 16, v4
    v_and_b32 v41, 0xffff0000, v4
    v_cvt_pk_bf16_f32 v4, v42, v43
    v_lshlrev_b32 v42, 16, v4
    v_and_b32 v43, 0xffff0000, v4
    v_cvt_pk_bf16_f32 v4, v44, v45
    v_lshlrev_b32 v44, 16, v4
    v_and_b32 v45, 0xffff0000, v4
    v_cvt_pk_bf16_f32 v4, v46, v47
    v_lshlrev_b32 v46, 16, v4
    v_and_b32 v47, 0xffff0000, v4
    v_mul_f32 v40, s71, v40
    v_mul_f32 v41, s71, v41
    v_mul_f32 v42, s71, v42
    v_mul_f32 v43, s71, v43
    v_mul_f32 v44, s71, v44
    v_mul_f32 v45, s71, v45
    v_mul_f32 v46, s71, v46
    v_mul_f32 v47, s71, v47
    v_cvt_pk_bf16_f32 v4, v40, v41
    v_lshlrev_b32 v40, 16, v4
    v_and_b32 v41, 0xffff0000, v4
    v_cvt_pk_bf16_f32 v4, v42, v43
    v_lshlrev_b32 v42, 16, v4
    v_and_b32 v43, 0xffff0000, v4
    v_cvt_pk_bf16_f32 v4, v44, v45
    v_lshlrev_b32 v44, 16, v4
    v_and_b32 v45, 0xffff0000, v4
    v_cvt_pk_bf16_f32 v4, v46, v47
    v_lshlrev_b32 v46, 16, v4
    v_and_b32 v47, 0xffff0000, v4
    v_max3_f32 v6, v40, v41, v42
    v_max3_f32 v6, v6, v43, v44
    v_max3_f32 v6, v6, v45, v46
    v_max_f32 v6, v6, v47
    v_mov_b32 v7, v6
    s_nop 1
    v_permlane16_swap_b32 v6, v7
    v_max_f32 v6, v6, v7
    v_mov_b32 v7, v6
    s_nop 1
    v_permlane32_swap_b32 v6, v7
    v_max_f32 v6, v6, v7
    s_lshl_b32 s77, s32, 2
    v_add_u32 v8, s77, v25
    ds_write_b32 v8, v6
    s_mov_b64 exec, 1
    ds_add_u32 v16, v154 offset:32
    s_mov_b64 exec, -1
    s_mov_b32 s81, 0
L_w_8:
    ds_read_b32 v11, v16 offset:32
    s_add_u32 s81, s81, 1
    s_cmp_ge_u32 s81, 2000000
    s_cbranch_scc1 L_w_8x
    s_waitcnt lgkmcnt(0)
    v_readfirstlane_b32 s79, v11
    s_nop 0
    s_cmp_ge_u32 s79, 8
    s_cbranch_scc0 L_w_8
L_w_8x:
    s_waitcnt lgkmcnt(0)
    ds_read_b128 v[48:51], v25
    ds_read_b128 v[52:55], v25 offset:16
    s_waitcnt lgkmcnt(0)
    v_max3_f32 v26, v48, v49, v50
    v_max3_f32 v26, v26, v51, v52
    v_max3_f32 v26, v26, v53, v54
    v_max_f32 v26, v26, v55
    v_mul_f32 v4, s70, v26
    v_sub_f32 v4, 0, v4
    v_fma_f32 v40, v40, s70, v4
    v_fma_f32 v41, v41, s70, v4
    v_fma_f32 v42, v42, s70, v4
    v_fma_f32 v43, v43, s70, v4
    v_fma_f32 v44, v44, s70, v4
    v_fma_f32 v45, v45, s70, v4
    v_fma_f32 v46, v46, s70, v4
    v_fma_f32 v47, v47, s70, v4
    v_exp_f32 v40, v40
    v_exp_f32 v41, v41
    v_exp_f32 v42, v42
    v_exp_f32 v43, v43
    v_exp_f32 v44, v44
    v_exp_f32 v45, v45
    v_exp_f32 v46, v46
    v_exp_f32 v47, v47
    v_add_f32 v5, v40, v41
    v_add_f32 v6, v42, v43
    v_add_f32 v7, v44, v45
    v_add_f32 v9, v46, v47
    v_add_f32 v5, v5, v6
    v_add_f32 v7, v7, v9
    v_add_f32 v5, v5, v7
    v_cvt_pk_bf16_f32 v48, v40, v41
    v_cvt_pk_bf16_f32 v49, v42, v43
    v_cvt_pk_bf16_f32 v50, v44, v45
    v_cvt_pk_bf16_f32 v51, v46, v47
    v_mul_u32_u24 v6, 544, v17
    v_lshl_add_u32 v6, v3, 3, v6
    s_lshl_b32 s77, s32, 6
    s_add_u32 s77, s77, 147456
    v_add_u32 v6, s77, v6
    ds_write_b64 v6, v[48:49]
    ds_write_b64 v6, v[50:51] offset:32
    v_mov_b32 v7, v5
    s_nop 1
    v_permlane16_swap_b32 v5, v7
    v_add_f32 v5, v5, v7
    v_mov_b32 v7, v5
    s_nop 1
    v_permlane32_swap_b32 v5, v7
    v_add_f32 v5, v5, v7
    ds_write_b32 v8, v5 offset:256
    s_mov_b64 exec, 1
    ds_add_u32 v16, v154 offset:36
    s_mov_b64 exec, -1
    s_mov_b32 s81, 0
L_w_9:
    ds_read_b32 v11, v16 offset:36
    s_add_u32 s81, s81, 1
    s_cmp_ge_u32 s81, 2000000
    s_cbranch_scc1 L_w_9x
    s_waitcnt lgkmcnt(0)
    v_readfirstlane_b32 s79, v11
    s_nop 0
    s_cmp_ge_u32 s79, 8
    s_cbranch_scc0 L_w_9
L_w_9x:
    s_waitcnt lgkmcnt(0)
    ds_read_b128 v[64:67], v19 offset:0
    ds_read_b128 v[68:71], v19 offset:64
    ds_read_b128 v[72:75], v19 offset:128
    ds_read_b128 v[76:79], v19 offset:192
    ds_read_b128 v[80:83], v19 offset:256
    ds_read_b128 v[84:87], v19 offset:320
    ds_read_b128 v[88:91], v19 offset:384
    ds_read_b128 v[92:95], v19 offset:448
    s_cmp_eq_u32 s32, 7
    s_cbranch_scc0 L_noml
    ds_read_b128 v[48:51], v25 offset:256
    ds_read_b128 v[52:55], v25 offset:272
    s_lshl_b32 s77, s33, 12
    s_lshl_b32 s78, s36, 7
    s_add_u32 s77, s77, s78
    s_add_u32 s77, s77, 393216
    v_lshlrev_b32 v4, 4, v17
    s_waitcnt lgkmcnt(0)
    v_add_f32 v48, v48, v49
    v_add_f32 v50, v50, v51
    v_add_f32 v52, v52, v53
    v_add_f32 v54, v54, v55
    v_add_f32 v48, v48, v50
    v_add_f32 v52, v52, v54
    v_add_f32 v49, v48, v52
    v_mov_b32 v48, v26
    v_mov_b32 v50, 0
    v_mov_b32 v51, 0
    v_and_or_b32 v48, v48, s69, v12
    v_and_or_b32 v49, v49, s69, v13
    v_and_or_b32 v50, v50, s69, v14
    v_and_or_b32 v51, v51, s69, v15
    s_mov_b64 exec, 0xff
    s_cmp_eq_u32 s86, 1
    s_cbranch_scc1 L_st_10f
    buffer_store_dwordx4 v[48:51], v4, s[56:59], s77 offen sc1
    s_branch L_st_10d
L_st_10f:
    buffer_store_dwordx4 v[48:51], v4, s[56:59], s77 offen
L_st_10d:
    s_mov_b64 exec, -1
L_noml:
    s_mov_b32 s81, 0
L_w_11:
    ds_read_b32 v11, v16 offset:12
    s_add_u32 s81, s81, 1
    s_cmp_ge_u32 s81, 2000000
    s_cbranch_scc1 L_w_11x
    s_waitcnt lgkmcnt(0)
    v_readfirstlane_b32 s79, v11
    s_nop 0
    s_cmp_ge_u32 s79, 1
    s_cbranch_scc0 L_w_11
L_w_11x:
    s_waitcnt lgkmcnt(0)
    ds_read_b64_tr_b16 v[96:97], v20 offset:0
    ds_read_b64_tr_b16 v[98:99], v20 offset:1024
    ds_read_b64_tr_b16 v[100:101], v20 offset:8192
    ds_read_b64_tr_b16 v[102:103], v20 offset:9216
    ds_read_b64_tr_b16 v[104:105], v20 offset:16384
    ds_read_b64_tr_b16 v[106:107], v20 offset:17408
    ds_read_b64_tr_b16 v[108:109], v20 offset:24576
    ds_read_b64_tr_b16 v[110:111], v20 offset:25600
    ds_read_b64_tr_b16 v[112:113], v20 offset:32768
    ds_read_b64_tr_b16 v[114:115], v20 offset:33792
    ds_read_b64_tr_b16 v[116:117], v20 offset:40960
    ds_read_b64_tr_b16 v[118:119], v20 offset:41984
    ds_read_b64_tr_b16 v[120:121], v20 offset:49152
    ds_read_b64_tr_b16 v[122:123], v20 offset:50176
    ds_read_b64_tr_b16 v[124:125], v20 offset:57344
    ds_read_b64_tr_b16 v[126:127], v20 offset:58368
    s_waitcnt lgkmcnt(14)
    v_mfma_f32_16x16x32_bf16 v[40:43], v[96:99], v[64:67], 0
    s_waitcnt lgkmcnt(12)
    v_mfma_f32_16x16x32_bf16 v[40:43], v[100:103], v[68:71], v[40:43]
    s_waitcnt lgkmcnt(10)
    v_mfma_f32_16x16x32_bf16 v[40:43], v[104:107], v[72:75], v[40:43]
    s_waitcnt lgkmcnt(8)
    v_mfma_f32_16x16x32_bf16 v[40:43], v[108:111], v[76:79], v[40:43]
    s_waitcnt lgkmcnt(6)
    v_mfma_f32_16x16x32_bf16 v[40:43], v[112:115], v[80:83], v[40:43]
    s_waitcnt lgkmcnt(4)
    v_mfma_f32_16x16x32_bf16 v[40:43], v[116:119], v[84:87], v[40:43]
    s_waitcnt lgkmcnt(2)
    v_mfma_f32_16x16x32_bf16 v[40:43], v[120:123], v[88:91], v[40:43]
    s_waitcnt lgkmcnt(0)
    v_mfma_f32_16x16x32_bf16 v[40:43], v[124:127], v[92:95], v[40:43]
    s_nop 7
    v_and_or_b32 v40, v40, s69, v12
    v_and_or_b32 v41, v41, s69, v13
    v_and_or_b32 v42, v42, s69, v14
    v_and_or_b32 v43, v43, s69, v15
    s_mov_b32 exec_lo, 0x00ff00ff
    s_mov_b32 exec_hi, 0x00ff00ff
    s_cmp_eq_u32 s86, 1
    s_cbranch_scc1 L_st_12f
    buffer_store_dwordx4 v[40:43], v153, s[56:59], 0 offen sc1
    s_branch L_st_12d
L_st_12f:
    buffer_store_dwordx4 v[40:43], v153, s[56:59], 0 offen
L_st_12d:
    s_mov_b64 exec, -1
    s_cmp_eq_u32 s32, 7
    s_cbranch_scc0 L_now
    s_mov_b32 s76, 0
    buffer_load_dwordx4 v[144:147], v30, s[56:59], 0 offen sc1
    s_waitcnt vmcnt(0)
    v_xor_b32 v144, v144, v12
    v_xor_b32 v145, v145, v13
    v_xor_b32 v146, v146, v14
    v_xor_b32 v147, v147, v15
    v_or3_b32 v4, v144, v145, v146
    v_or_b32 v4, v4, v147
    v_and_b32 v4, 0xff, v4
    v_cmp_ne_u32 s[88:89], 0, v4
    s_nop 0
    s_cmp_eq_u64 s[88:89], 0
    s_cbranch_scc1 L_ml_ok
L_ml_retry:
    s_add_u32 s76, s76, 1
    s_cmp_ge_u32 s76, 200000
    s_cbranch_scc1 L_ml_out
    s_mov_b64 exec, s[88:89]
    buffer_load_dwordx4 v[144:147], v30, s[56:59], 0 offen sc1
    s_waitcnt vmcnt(0)
    v_xor_b32 v144, v144, v12
    v_xor_b32 v145, v145, v13
    v_xor_b32 v146, v146, v14
    v_xor_b32 v147, v147, v15
    v_or3_b32 v4, v144, v145, v146
    v_or_b32 v4, v4, v147
    v_and_b32 v4, 0xff, v4
    v_cmp_ne_u32 s[88:89], 0, v4
    s_nop 0
    s_cmp_lg_u64 s[88:89], 0
    s_cbranch_scc1 L_ml_retry
L_ml_out:
    s_mov_b64 exec, -1
L_ml_ok:
    v_max_f32_dpp v5, v144, v144 row_ror:4 row_mask:0xf bank_mask:0xf
    s_nop 1
    v_max_f32_dpp v5, v5, v5 row_ror:8 row_mask:0xf bank_mask:0xf
    v_mov_b32 v6, v5
    s_nop 1
    v_permlane16_swap_b32 v5, v6
    v_max_f32 v5, v5, v6
    v_mov_b32 v6, v5
    s_nop 1
    v_permlane32_swap_b32 v5, v6
    v_max_f32 v5, v5, v6
    v_sub_f32 v6, v144, v5
    v_mul_f32 v6, s70, v6
    v_exp_f32 v6, v6
    s_nop 0
    v_mul_f32 v7, v6, v145
    s_nop 1
    v_add_f32_dpp v7, v7, v7 row_ror:4 row_mask:0xf bank_mask:0xf
    s_nop 1
    v_add_f32_dpp v7, v7, v7 row_ror:8 row_mask:0xf bank_mask:0xf
    v_mov_b32 v8, v7
    s_nop 1
    v_permlane16_swap_b32 v7, v8
    v_add_f32 v7, v7, v8
    v_mov_b32 v8, v7
    s_nop 1
    v_permlane32_swap_b32 v7, v8
    v_add_f32 v7, v7, v8
    v_rcp_f32 v7, v7
    s_nop 0
    v_mul_f32 v6, v6, v7
    v_and_b32 v7, 1, v1
    v_lshrrev_b32 v8, 2, v1
    v_lshlrev_b32 v7, 6, v7
    v_lshl_add_u32 v7, v8, 2, v7
    v_add_u32 v7, 160544, v7
    ds_write_b32 v7, v6
    s_mov_b64 exec, 1
    ds_write_b32 v16, v154 offset:52
    s_mov_b64 exec, -1
L_now:
    s_mov_b32 s81, 0
L_w_13:
    ds_read_b32 v11, v16 offset:48
    s_add_u32 s81, s81, 1
    s_cmp_ge_u32 s81, 2000000
    s_cbranch_scc1 L_w_13x
    s_waitcnt lgkmcnt(0)
    v_readfirstlane_b32 s79, v11
    s_nop 0
    s_cmp_ge_u32 s79, 1
    s_cbranch_scc0 L_w_13
L_w_13x:
    s_waitcnt lgkmcnt(0)
    buffer_load_dwordx4 v[48:51], v28, s[56:59], 0 offen
    buffer_load_dwordx4 v[52:55], v29, s[56:59], 0 offen
    ds_read_b64_tr_b16 v[96:97], v36 offset:0
    ds_read_b64_tr_b16 v[98:99], v36 offset:2048
    ds_read_b64_tr_b16 v[112:113], v37 offset:0
    ds_read_b64_tr_b16 v[114:115], v37 offset:2048
    ds_read_b64_tr_b16 v[100:101], v38 offset:0
    ds_read_b64_tr_b16 v[102:103], v38 offset:2048
    ds_read_b64_tr_b16 v[116:117], v39 offset:0
    ds_read_b64_tr_b16 v[118:119], v39 offset:2048
    ds_read_b64_tr_b16 v[104:105], v38 offset:16384
    ds_read_b64_tr_b16 v[106:107], v38 offset:18432
    ds_read_b64_tr_b16 v[120:121], v39 offset:16384
    ds_read_b64_tr_b16 v[122:123], v39 offset:18432
    s_mov_b32 s81, 0
L_w_14:
    ds_read_b32 v11, v16 offset:52
    s_add_u32 s81, s81, 1
    s_cmp_ge_u32 s81, 2000000
    s_cbranch_scc1 L_w_14x
    s_waitcnt lgkmcnt(0)
    v_readfirstlane_b32 s79, v11
    s_nop 0
    s_cmp_ge_u32 s79, 1
    s_cbranch_scc0 L_w_14
L_w_14x:
    s_waitcnt lgkmcnt(0)
    v_lshrrev_b32 v8, 3, v1
    v_lshlrev_b32 v8, 2, v8
    s_lshr_b32 s77, s32, 2
    s_lshl_b32 s77, s77, 6
    s_add_u32 s77, s77, 160544
    v_add_u32 v8, s77, v8
    ds_read2_b32 v[148:149], v8 offset0:0 offset1:8
    s_mov_b32 s76, 0
    s_waitcnt vmcnt(0)
    v_xor_b32 v48, v48, v12
    v_xor_b32 v49, v49, v13
    v_xor_b32 v50, v50, v14
    v_xor_b32 v51, v51, v15
    v_or3_b32 v4, v48, v49, v50
    v_or_b32 v4, v4, v51
    v_xor_b32 v52, v52, v12
    v_xor_b32 v53, v53, v13
    v_xor_b32 v54, v54, v14
    v_xor_b32 v55, v55, v15
    v_or3_b32 v4, v4, v52, v53
    v_or3_b32 v4, v4, v54, v55
    v_and_b32 v4, 0xff, v4
    v_cmp_ne_u32 s[82:83], 0, v4
    s_nop 0
    s_cmp_eq_u64 s[82:83], 0
    s_cbranch_scc1 L_h2_ok
L_h2_retry:
    s_add_u32 s76, s76, 1
    s_cmp_ge_u32 s76, 200000
    s_cbranch_scc1 L_h2_out
    s_mov_b64 exec, s[82:83]
    buffer_load_dwordx4 v[48:51], v28, s[56:59], 0 offen sc1
    buffer_load_dwordx4 v[52:55], v29, s[56:59], 0 offen sc1
    s_waitcnt vmcnt(0)
    v_xor_b32 v48, v48, v12
    v_xor_b32 v49, v49, v13
    v_xor_b32 v50, v50, v14
    v_xor_b32 v51, v51, v15
    v_or3_b32 v4, v48, v49, v50
    v_or_b32 v4, v4, v51
    v_xor_b32 v52, v52, v12
    v_xor_b32 v53, v53, v13
    v_xor_b32 v54, v54, v14
    v_xor_b32 v55, v55, v15
    v_or3_b32 v4, v4, v52, v53
    v_or3_b32 v4, v4, v54, v55
    v_and_b32 v4, 0xff, v4
    v_cmp_ne_u32 s[82:83], 0, v4
    s_nop 0
    s_cmp_lg_u64 s[82:83], 0
    s_cbranch_scc1 L_h2_retry
L_h2_out:
    s_mov_b64 exec, -1
L_h2_ok:
    s_waitcnt lgkmcnt(0)
    v_mul_f32 v48, v148, v48
    v_mul_f32 v49, v148, v49
    v_mul_f32 v50, v148, v50
    v_mul_f32 v51, v148, v51
    v_fma_f32 v48, v149, v52, v48
    v_fma_f32 v49, v149, v53, v49
    v_fma_f32 v50, v149, v54, v50
    v_fma_f32 v51, v149, v55, v51
    v_add_f32_dpp v48, v48, v48 row_ror:8 row_mask:0xf bank_mask:0xf
    v_add_f32_dpp v49, v49, v49 row_ror:8 row_mask:0xf bank_mask:0xf
    v_add_f32_dpp v50, v50, v50 row_ror:8 row_mask:0xf bank_mask:0xf
    v_add_f32_dpp v51, v51, v51 row_ror:8 row_mask:0xf bank_mask:0xf
    s_nop 0
    v_permlane32_swap_b32 v48, v50
    v_permlane32_swap_b32 v49, v51
    v_add_f32 v48, v48, v50
    v_add_f32 v49, v49, v51
    s_nop 1
    v_permlane16_swap_b32 v48, v49
    v_add_f32 v48, v48, v49
    v_cvt_pk_bf16_f32 v48, v48, v48
    ds_write_b16 v151, v48
    s_waitcnt lgkmcnt(0)
    s_barrier
    ds_read_b128 v[128:131], v161
    ds_read_b128 v[132:135], v162
    ds_read_b128 v[136:139], v163
    ds_read_b128 v[140:143], v164
    ds_read_b64_tr_b16 v[108:109], v38 offset:32768
    ds_read_b64_tr_b16 v[110:111], v38 offset:34816
    ds_read_b64_tr_b16 v[124:125], v39 offset:32768
    ds_read_b64_tr_b16 v[126:127], v39 offset:34816
    s_waitcnt lgkmcnt(7)
    v_mfma_f32_16x16x32_bf16 v[40:43], v[96:99], v[128:131], 0
    v_mfma_f32_16x16x32_bf16 v[44:47], v[112:115], v[128:131], 0
    s_waitcnt lgkmcnt(6)
    v_mfma_f32_16x16x32_bf16 v[40:43], v[100:103], v[132:135], v[40:43]
    v_mfma_f32_16x16x32_bf16 v[44:47], v[116:119], v[132:135], v[44:47]
    s_waitcnt lgkmcnt(5)
    v_mfma_f32_16x16x32_bf16 v[40:43], v[104:107], v[136:139], v[40:43]
    v_mfma_f32_16x16x32_bf16 v[44:47], v[120:123], v[136:139], v[44:47]
    s_waitcnt lgkmcnt(0)
    v_mfma_f32_16x16x32_bf16 v[40:43], v[108:111], v[140:143], v[40:43]
    v_mfma_f32_16x16x32_bf16 v[44:47], v[124:127], v[140:143], v[44:47]
    s_nop 6
    v_and_or_b32 v40, v40, s69, v12
    v_and_or_b32 v41, v41, s69, v13
    v_and_or_b32 v42, v42, s69, v14
    v_and_or_b32 v43, v43, s69, v15
    v_and_or_b32 v44, v44, s69, v12
    v_and_or_b32 v45, v45, s69, v13
    v_and_or_b32 v46, v46, s69, v14
    v_and_or_b32 v47, v47, s69, v15
    s_mov_b32 exec_lo, 0x00030003
    s_mov_b32 exec_hi, 0x00030003
    buffer_store_dwordx4 v[40:43], v31, s[56:59], 0 offen sc0 sc1
    buffer_store_dwordx4 v[44:47], v31, s[56:59], s85 offen sc0 sc1
    s_mov_b64 exec, -1
    s_cmp_eq_u32 s32, 1
    s_cbranch_scc0 L_fin
    s_cmp_lt_u32 s2, 128
    s_cbranch_scc0 L_fin
    s_waitcnt vmcnt(0)
    s_mov_b32 s76, 0
    buffer_load_dwordx4 v[96:99], v33, s[56:59], 0 offen offset:0 sc1
    buffer_load_dwordx4 v[100:103], v33, s[56:59], 0 offen offset:1024 sc1
    buffer_load_dwordx4 v[104:107], v33, s[56:59], 0 offen offset:2048 sc1
    buffer_load_dwordx4 v[108:111], v33, s[56:59], 0 offen offset:3072 sc1
    s_lshr_b32 s77, s2, 1
    s_lshl_b32 s77, s77, 5
    s_lshl_b32 s78, s92, 11
    s_add_u32 s75, s77, s78
    v_and_b32 v5, 3, v1
    v_lshlrev_b32 v5, 3, v5
    v_and_b32 v6, 1, v3
    v_lshl_add_u32 v5, v6, 1, v5
    s_waitcnt vmcnt(0)
    v_xor_b32 v96, v96, v12
    v_xor_b32 v97, v97, v13
    v_xor_b32 v98, v98, v14
    v_xor_b32 v99, v99, v15
    v_or3_b32 v4, v96, v97, v98
    v_or_b32 v4, v4, v99
    v_xor_b32 v100, v100, v12
    v_xor_b32 v101, v101, v13
    v_xor_b32 v102, v102, v14
    v_xor_b32 v103, v103, v15
    v_or3_b32 v4, v4, v100, v101
    v_or3_b32 v4, v4, v102, v103
    v_xor_b32 v104, v104, v12
    v_xor_b32 v105, v105, v13
    v_xor_b32 v106, v106, v14
    v_xor_b32 v107, v107, v15
    v_or3_b32 v4, v4, v104, v105
    v_or3_b32 v4, v4, v106, v107
    v_xor_b32 v108, v108, v12
    v_xor_b32 v109, v109, v13
    v_xor_b32 v110, v110, v14
    v_xor_b32 v111, v111, v15
    v_or3_b32 v4, v4, v108, v109
    v_or3_b32 v4, v4, v110, v111
    v_and_b32 v4, 0xff, v4
    v_cmp_ne_u32 s[82:83], 0, v4
    s_nop 0
    s_cmp_eq_u64 s[82:83], 0
    s_cbranch_scc1 L_h3_ok
L_h3_retry:
    s_add_u32 s76, s76, 1
    s_cmp_ge_u32 s76, 200000
    s_cbranch_scc1 L_h3_out
    s_mov_b64 exec, s[82:83]
    buffer_load_dwordx4 v[96:99], v33, s[56:59], 0 offen offset:0 sc1
    buffer_load_dwordx4 v[100:103], v33, s[56:59], 0 offen offset:1024 sc1
    buffer_load_dwordx4 v[104:107], v33, s[56:59], 0 offen offset:2048 sc1
    buffer_load_dwordx4 v[108:111], v33, s[56:59], 0 offen offset:3072 sc1
    s_waitcnt vmcnt(0)
    v_xor_b32 v96, v96, v12
    v_xor_b32 v97, v97, v13
    v_xor_b32 v98, v98, v14
    v_xor_b32 v99, v99, v15
    v_or3_b32 v4, v96, v97, v98
    v_or_b32 v4, v4, v99
    v_xor_b32 v100, v100, v12
    v_xor_b32 v101, v101, v13
    v_xor_b32 v102, v102, v14
    v_xor_b32 v103, v103, v15
    v_or3_b32 v4, v4, v100, v101
    v_or3_b32 v4, v4, v102, v103
    v_xor_b32 v104, v104, v12
    v_xor_b32 v105, v105, v13
    v_xor_b32 v106, v106, v14
    v_xor_b32 v107, v107, v15
    v_or3_b32 v4, v4, v104, v105
    v_or3_b32 v4, v4, v106, v107
    v_xor_b32 v108, v108, v12
    v_xor_b32 v109, v109, v13
    v_xor_b32 v110, v110, v14
    v_xor_b32 v111, v111, v15
    v_or3_b32 v4, v4, v108, v109
    v_or3_b32 v4, v4, v110, v111
    v_and_b32 v4, 0xff, v4
    v_cmp_ne_u32 s[82:83], 0, v4
    s_nop 0
    s_cmp_lg_u64 s[82:83], 0
    s_cbranch_scc1 L_h3_retry
L_h3_out:
    s_mov_b64 exec, -1
L_h3_ok:
    v_add_f32 v96, v96, v100
    v_add_f32 v104, v104, v108
    v_add_f32 v97, v97, v101
    v_add_f32 v105, v105, v109
    v_add_f32 v98, v98, v102
    v_add_f32 v106, v106, v110
    v_add_f32 v99, v99, v103
    v_add_f32 v107, v107, v111
    v_permlane32_swap_b32 v96, v104
    v_permlane32_swap_b32 v97, v105
    v_permlane32_swap_b32 v98, v106
    v_permlane32_swap_b32 v99, v107
    v_add_f32 v96, v96, v104
    v_add_f32 v97, v97, v105
    v_add_f32 v98, v98, v106
    v_add_f32 v99, v99, v107
    v_add_f32_dpp v96, v96, v96 row_ror:4 row_mask:0xf bank_mask:0xf
    v_add_f32_dpp v97, v97, v97 row_ror:4 row_mask:0xf bank_mask:0xf
    v_add_f32_dpp v98, v98, v98 row_ror:4 row_mask:0xf bank_mask:0xf
    v_add_f32_dpp v99, v99, v99 row_ror:4 row_mask:0xf bank_mask:0xf
    v_add_f32_dpp v96, v96, v96 row_ror:8 row_mask:0xf bank_mask:0xf
    v_add_f32_dpp v97, v97, v97 row_ror:8 row_mask:0xf bank_mask:0xf
    v_add_f32_dpp v98, v98, v98 row_ror:8 row_mask:0xf bank_mask:0xf
    v_add_f32_dpp v99, v99, v99 row_ror:8 row_mask:0xf bank_mask:0xf
    v_permlane16_swap_b32 v96, v97
    s_nop 0
    v_permlane16_swap_b32 v98, v99
    v_add_f32 v96, v96, v97
    v_add_f32 v98, v98, v99
    v_cvt_pk_bf16_f32 v4, v96, v98
    v_lshlrev_b32 v96, 16, v4
    v_and_b32 v98, 0xffff0000, v4
    v_mul_f32 v96, v34, v96
    v_mul_f32 v98, v34, v98
    v_cvt_pk_bf16_f32 v4, v96, v98
    v_lshlrev_b32 v96, 16, v4
    v_and_b32 v98, 0xffff0000, v4
    v_mov_b32 v104, v96
    v_mov_b32 v105, v98
    s_nop 0
    v_permlane32_swap_b32 v96, v104
    v_permlane32_swap_b32 v98, v105
    v_add_f32 v96, v96, v104
    v_add_f32 v98, v98, v105
    v_cvt_pk_bf16_f32 v96, v96, v98
    s_mov_b32 exec_lo, 0x000f000f
    s_mov_b32 exec_hi, 0
    buffer_store_short v96, v5, s[64:67], s75 offen
    buffer_store_short_d16_hi v96, v5, s[64:67], s75 offen offset:4
    s_cmp_eq_u32 s2, 0
    s_cbranch_scc0 L_noep
    s_mov_b64 exec, 1
    v_mov_b32 v5, s68
    v_mov_b32 v6, 0
    buffer_store_dword v5, v6, s[56:59], 0 offen
L_noep:
    s_mov_b64 exec, -1
    s_branch L_fin
L_loader:
    v_lshlrev_b32 v4, 1, v3
    v_xor_b32 v4, v2, v4
    v_lshlrev_b32 v4, 4, v4
    v_lshl_add_u32 v17, v3, 13, v4
    v_xor_b32 v18, 128, v17
    s_lshl_b32 s72, s84, 21
    s_lshl_b32 s77, s35, 3
    s_add_u32 s77, s77, s39
    s_lshl_b32 s78, s77, 8
    s_add_u32 s72, s72, s78
    s_lshl_b32 s74, s77, 18
    s_lshl_b32 s78, s84, 9
    s_add_u32 s74, s74, s78
    s_mul_i32 s60, s38, 1
    s_lshl_b32 s61, s33, 1
    s_add_u32 s61, s61, s37
    s_mul_i32 s61, s61, 5
    s_add_u32 s60, s60, s61
    s_and_b32 s60, s60, 15
    s_lshl_b32 s60, s60, 12
    s_cmp_eq_u32 s34, 0
    s_waitcnt lgkmcnt(0)
    s_cselect_b32 s40, s10, s20
    s_cselect_b32 s41, s11, s21
    s_mov_b32 s42, 8388608
    s_mov_b32 s43, 0x20000
    s_mov_b32 s75, 65536
    s_add_u32 m0, s60, 65536
    s_lshl_b32 s61, s60, 5
    s_add_u32 s61, s61, s72
    s_add_u32 s60, s60, 1024
    buffer_load_dwordx4 v17, s[40:43], s61 offen nt lds
    s_and_b32 s60, s60, 0xffff
    s_add_u32 m0, s60, 65536
    s_lshl_b32 s61, s60, 5
    s_add_u32 s61, s61, s72
    s_add_u32 s60, s60, 1024
    buffer_load_dwordx4 v17, s[40:43], s61 offen nt lds
    s_and_b32 s60, s60, 0xffff
    s_add_u32 m0, s60, 65536
    s_lshl_b32 s61, s60, 5
    s_add_u32 s61, s61, s72
    s_add_u32 s60, s60, 1024
    buffer_load_dwordx4 v18, s[40:43], s61 offen nt lds
    s_and_b32 s60, s60, 0xffff
    s_add_u32 m0, s60, 65536
    s_lshl_b32 s61, s60, 5
    s_add_u32 s61, s61, s72
    s_add_u32 s60, s60, 1024
    buffer_load_dwordx4 v18, s[40:43], s61 offen nt lds
    s_and_b32 s60, s60, 0xffff
    s_cmp_eq_u32 s34, 0
    s_cselect_b32 s44, s6, s16
    s_cselect_b32 s45, s7, s17
    s_mov_b32 s46, 67108864
    s_mov_b32 s47, 0x20000
    s_cselect_b32 s48, s8, s18
    s_cselect_b32 s49, s9, s19
    s_mov_b32 s50, 67108864
    s_mov_b32 s51, 0x20000
    s_cselect_b32 s52, s12, s22
    s_cselect_b32 s53, s13, s23
    s_mov_b32 s54, 8388608
    s_mov_b32 s55, 0x20000
    s_mov_b32 s56, s30
    s_and_b32 s57, s31, 0xffff
    s_mov_b32 s58, 302000128
    s_mov_b32 s59, 0x20000
    s_lshl_b32 s73, s37, 2
    s_add_u32 s73, s73, s35
    s_lshl_b32 s73, s73, 23
    s_add_u32 s73, s73, 7340032
    s_lshl_b32 s77, s38, 16
    s_add_u32 s73, s73, s77
    v_xor_b32 v4, v2, v3
    v_lshlrev_b32 v4, 4, v4
    v_lshl_add_u32 v19, v3, 8, v4
    v_xor_b32 v20, 64, v19
    v_xor_b32 v21, 128, v19
    v_xor_b32 v22, 192, v19
    v_lshlrev_b32 v4, 1, v3
    v_xor_b32 v4, v2, v4
    v_lshlrev_b32 v4, 4, v4
    v_lshl_add_u32 v28, v3, 8, v4
    v_xor_b32 v29, 128, v28
    v_lshrrev_b32 v4, 5, v1
    v_and_b32 v5, 31, v1
    v_lshlrev_b32 v6, 1, v4
    v_xor_b32 v5, v5, v6
    v_lshlrev_b32 v5, 4, v5
    v_lshl_add_u32 v23, v4, 11, v5
    v_xor_b32 v24, 64, v23
    v_xor_b32 v25, 128, v23
    v_xor_b32 v26, 192, v23
    s_mov_b32 s93, 1
L_ld_q:
    s_add_u32 m0, s60, 65536
    s_lshl_b32 s61, s60, 5
    s_add_u32 s61, s61, s72
    s_add_u32 s60, s60, 1024
    buffer_load_dwordx4 v17, s[40:43], s61 offen nt lds
    s_and_b32 s60, s60, 0xffff
    s_waitcnt vmcnt(26)
    s_add_u32 m0, s60, 65536
    s_lshl_b32 s61, s60, 5
    s_add_u32 s61, s61, s72
    s_add_u32 s60, s60, 1024
    buffer_load_dwordx4 v17, s[40:43], s61 offen nt lds
    s_and_b32 s60, s60, 0xffff
    s_waitcnt vmcnt(26)
    s_add_u32 m0, s60, 65536
    s_lshl_b32 s61, s60, 5
    s_add_u32 s61, s61, s72
    s_add_u32 s60, s60, 1024
    buffer_load_dwordx4 v18, s[40:43], s61 offen nt lds
    s_and_b32 s60, s60, 0xffff
    s_waitcnt vmcnt(26)
    s_add_u32 m0, s60, 65536
    s_lshl_b32 s61, s60, 5
    s_add_u32 s61, s61, s72
    s_add_u32 s60, s60, 1024
    buffer_load_dwordx4 v18, s[40:43], s61 offen nt lds
    s_and_b32 s60, s60, 0xffff
    s_waitcnt vmcnt(26)
    s_add_u32 s93, s93, 1
    s_cmp_eq_u32 s93, 4
    s_cbranch_scc1 L_ld_q_e4
L_ld_q_c:
    s_cmp_lt_u32 s93, 16
    s_cbranch_scc1 L_ld_q
    s_mov_b32 s75, 0
    s_mul_i32 s60, s38, 1
    s_lshl_b32 s61, s33, 1
    s_add_u32 s61, s61, s37
    s_mul_i32 s61, s61, 5
    s_add_u32 s60, s60, s61
    s_and_b32 s60, s60, 15
    s_lshl_b32 s60, s60, 12
    s_mov_b32 s93, 0
L_ld_k:
    s_add_u32 m0, s60, 0
    s_add_u32 s61, s60, s73
    s_add_u32 s60, s60, 1024
    buffer_load_dwordx4 v19, s[44:47], s61 offen nt lds
    s_and_b32 s60, s60, 0xffff
    s_waitcnt vmcnt(28)
    s_add_u32 m0, s60, 0
    s_add_u32 s61, s60, s73
    s_add_u32 s60, s60, 1024
    buffer_load_dwordx4 v20, s[44:47], s61 offen nt lds
    s_and_b32 s60, s60, 0xffff
    s_waitcnt vmcnt(28)
    s_add_u32 m0, s60, 0
    s_add_u32 s61, s60, s73
    s_add_u32 s60, s60, 1024
    buffer_load_dwordx4 v21, s[44:47], s61 offen nt lds
    s_and_b32 s60, s60, 0xffff
    s_waitcnt vmcnt(28)
    s_add_u32 m0, s60, 0
    s_add_u32 s61, s60, s73
    s_add_u32 s60, s60, 1024
    buffer_load_dwordx4 v22, s[44:47], s61 offen nt lds
    s_and_b32 s60, s60, 0xffff
    s_waitcnt vmcnt(28)
    s_add_u32 s93, s93, 1
    s_cmp_eq_u32 s93, 7
    s_cbranch_scc1 L_ld_k_e7
L_ld_k_c:
    s_cmp_lt_u32 s93, 16
    s_cbranch_scc1 L_ld_k
    v_mov_b32 v27, 1
    ds_write_b32 v16, v27 offset:4
    s_mov_b32 s81, 0
L_w_15:
    ds_read_b32 v11, v16 offset:24
    s_add_u32 s81, s81, 1
    s_cmp_ge_u32 s81, 2000000
    s_cbranch_scc1 L_w_15x
    s_waitcnt lgkmcnt(0)
    v_readfirstlane_b32 s79, v11
    s_nop 0
    s_cmp_ge_u32 s79, 8
    s_cbranch_scc0 L_w_15
L_w_15x:
    s_waitcnt lgkmcnt(0)
    s_mov_b32 s75, 65536
    s_mov_b32 s93, 0
L_ld_v:
    s_add_u32 m0, s60, 65536
    s_add_u32 s61, s60, s73
    s_add_u32 s60, s60, 1024
    buffer_load_dwordx4 v28, s[48:51], s61 offen nt lds
    s_and_b32 s60, s60, 0xffff
    s_waitcnt vmcnt(28)
    s_add_u32 m0, s60, 65536
    s_add_u32 s61, s60, s73
    s_add_u32 s60, s60, 1024
    buffer_load_dwordx4 v28, s[48:51], s61 offen nt lds
    s_and_b32 s60, s60, 0xffff
    s_waitcnt vmcnt(28)
    s_add_u32 m0, s60, 65536
    s_add_u32 s61, s60, s73
    s_add_u32 s60, s60, 1024
    buffer_load_dwordx4 v29, s[48:51], s61 offen nt lds
    s_and_b32 s60, s60, 0xffff
    s_waitcnt vmcnt(28)
    s_add_u32 m0, s60, 65536
    s_add_u32 s61, s60, s73
    s_add_u32 s60, s60, 1024
    buffer_load_dwordx4 v29, s[48:51], s61 offen nt lds
    s_and_b32 s60, s60, 0xffff
    s_waitcnt vmcnt(28)
    s_add_u32 s93, s93, 1
    s_cmp_eq_u32 s93, 7
    s_cbranch_scc1 L_ld_v_e7
L_ld_v_c:
    s_cmp_lt_u32 s93, 16
    s_cbranch_scc1 L_ld_v
    s_mov_b32 s75, 131072
    s_mul_i32 s60, s38, 1
    s_lshl_b32 s61, s33, 1
    s_add_u32 s61, s61, s37
    s_mul_i32 s61, s61, 5
    s_add_u32 s60, s60, s61
    s_and_b32 s60, s60, 15
    s_lshl_b32 s60, s60, 12
    s_lshl_b32 s60, s60, 2
    s_mov_b32 s93, 0
L_ld_o0:
    s_mov_b32 m0, s75
    s_add_u32 s75, s75, 1024
    s_add_u32 s61, s60, s74
    s_add_u32 s60, s60, 4096
    buffer_load_dwordx4 v23, s[52:55], s61 offen nt lds
    s_and_b32 s60, s60, 0x3ffff
    s_waitcnt vmcnt(28)
    s_mov_b32 m0, s75
    s_add_u32 s75, s75, 1024
    s_add_u32 s61, s60, s74
    s_add_u32 s60, s60, 4096
    buffer_load_dwordx4 v24, s[52:55], s61 offen nt lds
    s_and_b32 s60, s60, 0x3ffff
    s_waitcnt vmcnt(28)
    s_mov_b32 m0, s75
    s_add_u32 s75, s75, 1024
    s_add_u32 s61, s60, s74
    s_add_u32 s60, s60, 4096
    buffer_load_dwordx4 v23, s[52:55], s61 offen nt lds
    s_and_b32 s60, s60, 0x3ffff
    s_waitcnt vmcnt(28)
    s_mov_b32 m0, s75
    s_add_u32 s75, s75, 1024
    s_add_u32 s61, s60, s74
    s_add_u32 s60, s60, 4096
    buffer_load_dwordx4 v24, s[52:55], s61 offen nt lds
    s_and_b32 s60, s60, 0x3ffff
    s_waitcnt vmcnt(28)
    s_mov_b32 m0, s75
    s_add_u32 s75, s75, 1024
    s_add_u32 s61, s60, s74
    s_add_u32 s60, s60, 4096
    buffer_load_dwordx4 v25, s[52:55], s61 offen nt lds
    s_and_b32 s60, s60, 0x3ffff
    s_waitcnt vmcnt(28)
    s_mov_b32 m0, s75
    s_add_u32 s75, s75, 1024
    s_add_u32 s61, s60, s74
    s_add_u32 s60, s60, 4096
    buffer_load_dwordx4 v26, s[52:55], s61 offen nt lds
    s_and_b32 s60, s60, 0x3ffff
    s_waitcnt vmcnt(28)
    s_mov_b32 m0, s75
    s_add_u32 s75, s75, 1024
    s_add_u32 s61, s60, s74
    s_add_u32 s60, s60, 4096
    buffer_load_dwordx4 v25, s[52:55], s61 offen nt lds
    s_and_b32 s60, s60, 0x3ffff
    s_waitcnt vmcnt(28)
    s_mov_b32 m0, s75
    s_add_u32 s75, s75, 1024
    s_add_u32 s61, s60, s74
    s_add_u32 s60, s60, 4096
    buffer_load_dwordx4 v26, s[52:55], s61 offen nt lds
    s_and_b32 s60, s60, 0x3ffff
    s_waitcnt vmcnt(28)
    s_add_u32 s93, s93, 1
L_ld_o0_c:
    s_cmp_lt_u32 s93, 2
    s_cbranch_scc1 L_ld_o0
    s_mov_b32 s81, 0
L_w_16:
    ds_read_b32 v11, v16 offset:32
    s_add_u32 s81, s81, 1
    s_cmp_ge_u32 s81, 2000000
    s_cbranch_scc1 L_w_16x
    s_waitcnt lgkmcnt(0)
    v_readfirstlane_b32 s79, v11
    s_nop 0
    s_cmp_ge_u32 s79, 8
    s_cbranch_scc0 L_w_16
L_w_16x:
    s_waitcnt lgkmcnt(0)
    s_mov_b32 s75, 0
    s_mov_b32 s93, 0
L_ld_o1:
    s_mov_b32 m0, s75
    s_add_u32 s75, s75, 1024
    s_add_u32 s61, s60, s74
    s_add_u32 s60, s60, 4096
    buffer_load_dwordx4 v23, s[52:55], s61 offen nt lds
    s_and_b32 s60, s60, 0x3ffff
    s_waitcnt vmcnt(28)
    s_mov_b32 m0, s75
    s_add_u32 s75, s75, 1024
    s_add_u32 s61, s60, s74
    s_add_u32 s60, s60, 4096
    buffer_load_dwordx4 v24, s[52:55], s61 offen nt lds
    s_and_b32 s60, s60, 0x3ffff
    s_waitcnt vmcnt(28)
    s_mov_b32 m0, s75
    s_add_u32 s75, s75, 1024
    s_add_u32 s61, s60, s74
    s_add_u32 s60, s60, 4096
    buffer_load_dwordx4 v23, s[52:55], s61 offen nt lds
    s_and_b32 s60, s60, 0x3ffff
    s_waitcnt vmcnt(28)
    s_mov_b32 m0, s75
    s_add_u32 s75, s75, 1024
    s_add_u32 s61, s60, s74
    s_add_u32 s60, s60, 4096
    buffer_load_dwordx4 v24, s[52:55], s61 offen nt lds
    s_and_b32 s60, s60, 0x3ffff
    s_waitcnt vmcnt(28)
    s_mov_b32 m0, s75
    s_add_u32 s75, s75, 1024
    s_add_u32 s61, s60, s74
    s_add_u32 s60, s60, 4096
    buffer_load_dwordx4 v25, s[52:55], s61 offen nt lds
    s_and_b32 s60, s60, 0x3ffff
    s_waitcnt vmcnt(28)
    s_mov_b32 m0, s75
    s_add_u32 s75, s75, 1024
    s_add_u32 s61, s60, s74
    s_add_u32 s60, s60, 4096
    buffer_load_dwordx4 v26, s[52:55], s61 offen nt lds
    s_and_b32 s60, s60, 0x3ffff
    s_waitcnt vmcnt(28)
    s_mov_b32 m0, s75
    s_add_u32 s75, s75, 1024
    s_add_u32 s61, s60, s74
    s_add_u32 s60, s60, 4096
    buffer_load_dwordx4 v25, s[52:55], s61 offen nt lds
    s_and_b32 s60, s60, 0x3ffff
    s_waitcnt vmcnt(28)
    s_mov_b32 m0, s75
    s_add_u32 s75, s75, 1024
    s_add_u32 s61, s60, s74
    s_add_u32 s60, s60, 4096
    buffer_load_dwordx4 v26, s[52:55], s61 offen nt lds
    s_and_b32 s60, s60, 0x3ffff
    s_waitcnt vmcnt(28)
    s_add_u32 s93, s93, 1
    s_cmp_eq_u32 s93, 2
    s_cbranch_scc1 L_ld_o1_e2
    s_cmp_eq_u32 s93, 4
    s_cbranch_scc1 L_ld_o1_e4
L_ld_o1_c:
    s_cmp_lt_u32 s93, 6
    s_cbranch_scc1 L_ld_o1
    v_mov_b32 v27, 2
    ds_write_b32 v16, v27 offset:16
    s_waitcnt vmcnt(16)
    v_mov_b32 v27, 3
    ds_write_b32 v16, v27 offset:16
    s_waitcnt vmcnt(12)
    v_mov_b32 v27, 1
    ds_write_b32 v16, v27 offset:48
    s_branch L_loader_done
L_ld_q_e4:
    s_barrier
    s_branch L_ld_q_c
L_ld_k_e7:
    v_mov_b32 v27, 1
    ds_write_b32 v16, v27 offset:0
    s_branch L_ld_k_c
L_ld_v_e7:
    v_mov_b32 v27, 1
    ds_write_b32 v16, v27 offset:8
    s_branch L_ld_v_c
L_ld_o1_e2:
    v_mov_b32 v27, 1
    ds_write_b32 v16, v27 offset:12
    s_branch L_ld_o1_c
L_ld_o1_e4:
    v_mov_b32 v27, 1
    ds_write_b32 v16, v27 offset:16
    s_branch L_ld_o1_c
L_loader_done:
    s_waitcnt vmcnt(0)
    s_barrier
L_fin:
L_end:
    s_endpgm

.section .rodata,"a"
.p2align 6
.amdhsa_kernel gated_mix__sliding_block_cached__sliding_block_cached__decode_kernel
  .amdhsa_next_free_vgpr 168
  .amdhsa_next_free_sgpr 102
  .amdhsa_accum_offset 168
  .amdhsa_group_segment_fixed_size 0
  .amdhsa_kernarg_size 112
  .amdhsa_user_sgpr_count 2
  .amdhsa_user_sgpr_kernarg_segment_ptr 1
  .amdhsa_system_sgpr_workgroup_id_x 1
.end_amdhsa_kernel
```
